```python
import torch

def _softmax(x, axis=-1):
    return torch.softmax(x, dim=axis)

def _gelu(x):
    return torch.nn.functional.gelu(x, approximate='tanh')

def _silu(x):
    return torch.nn.functional.silu(x)

def _sigmoid(x):
    return torch.sigmoid(x)

def _layernorm(x, axis=-1, eps=1e-05):
    m = x.mean(dim=axis, keepdim=True)
    v = x.var(dim=axis, keepdim=True, unbiased=False)
    return (x - m) / torch.sqrt(v + eps)

def _scatter_add(tgt, idx, src, axis=0):
    return tgt.clone().index_add_(axis, idx, src)

def _segment_sum(src, seg, n):
    out = torch.zeros((n,) + src.shape[1:], dtype=src.dtype)
    return out.index_add_(0, seg, src)

def _pad(x, pw):
    flat = tuple((v for pair in reversed(pw) for v in pair))
    return torch.nn.functional.pad(x, flat)
kernel_name = 'standalone__tree_speculative_verify_tree_attention_over_candidate_token_tree__sampling'

def setup_inputs():

    _w = lambda a: (lambda t: t.to(torch.bfloat16) if t.is_floating_point() else t)(torch.as_tensor(a))
    B, Hq, Hkv, T, C, D = (16, 32, 8, 8, 2048, 128)
    tree_mask = torch.zeros((B, T, T), dtype=float)
    for b in range(B):
        parent = torch.zeros(T, dtype=torch.int64)
        for i in range(1, T):
            parent[i] = int(torch.randint(0, i, (1,)).item())
        for i in range(T):
            j = i
            tree_mask[b, i, j] = 1.0
            while j > 0:
                j = parent[j]
                tree_mask[b, i, j] = 1.0
    return {'q': _w((lambda *s: torch.randn(*s, dtype=torch.bfloat16) * 0.8)(B, Hq, T, D)), 'k_cache': _w((lambda *s: torch.randn(*s, dtype=torch.bfloat16) * 0.8)(B, Hkv, C, D)), 'v_cache': _w((lambda *s: torch.randn(*s, dtype=torch.bfloat16) * 0.05)(B, Hkv, C, D)), 'k_tree': _w((lambda *s: torch.randn(*s, dtype=torch.bfloat16) * 0.8)(B, Hkv, T, D)), 'v_tree': _w((lambda *s: torch.randn(*s, dtype=torch.bfloat16) * 0.05)(B, Hkv, T, D)), 'tree_mask': _w(tree_mask)}

def reference(q, k_cache, v_cache, k_tree, v_tree, tree_mask):
    B, Hq, T, D = q.shape
    Hkv, C = (k_cache.shape[1], k_cache.shape[2])
    rep = Hq // Hkv
    kc = (lambda x, n, axis: torch.repeat_interleave(x, n, dim=axis))(k_cache, rep, axis=1)
    vc = (lambda x, n, axis: torch.repeat_interleave(x, n, dim=axis))(v_cache, rep, axis=1)
    kt = (lambda x, n, axis: torch.repeat_interleave(x, n, dim=axis))(k_tree, rep, axis=1)
    vt = (lambda x, n, axis: torch.repeat_interleave(x, n, dim=axis))(v_tree, rep, axis=1)
    k = torch.concatenate([kc, kt], axis=2)
    v = torch.concatenate([vc, vt], axis=2)
    scale = D ** (-0.5)
    scores = torch.einsum('bhqd,bhkd->bhqk', q, k) * scale
    ctx_mask = torch.ones((B, 1, T, C), dtype=scores.dtype)
    tm = tree_mask[:, None, :, :].clone()
    full_mask = torch.concatenate([ctx_mask, tm], axis=-1)
    scores = scores + (1.0 - full_mask) * -1000000000.0
    p = _softmax(scores, axis=-1)
    return torch.einsum('bhqk,bhkd->bhqd', p, v)
```

```asm
; @launch grid=(256,1,1) block=(320,1,1) lds=159744
.amdgcn_target "amdgcn-amd-amdhsa--gfx950"
.text
.globl standalone__tree_speculative_verify_tree_attention_over_candidate_token_tree__sampling_kernel
.p2align 8
.type standalone__tree_speculative_verify_tree_attention_over_candidate_token_tree__sampling_kernel,@function
standalone__tree_speculative_verify_tree_attention_over_candidate_token_tree__sampling_kernel:
  s_load_dwordx16 s[4:19], s[0:1], 0
  s_cmp_ge_u32 s2, 256
  s_cbranch_scc1 L_end
  v_lshrrev_b32 v8, 6, v0
  v_and_b32 v0, 63, v0
  s_bfe_u32 s61, s2, 65539
  s_lshr_b32 s60, s2, 4
  s_lshl_b32 s60, s60, 3
  s_and_b32 s3, s2, 7
  s_or_b32 s60, s60, s3
  v_readfirstlane_b32 s62, v8
  s_lshl_b32 s22, s60, 19
  s_lshl_b32 s3, s61, 14
  s_add_u32 s22, s22, s3
  v_lshrrev_b32 v9, 4, v0
  v_lshlrev_b32 v10, 1, v9
  v_xor_b32 v10, v10, v0
  v_and_b32 v10, 15, v10
  s_sub_u32 s62, s62, 1
  s_cbranch_scc0 L_comp
L_loader:
  v_lshlrev_b32 v1, 12, v9
  v_lshl_add_u32 v1, v10, 4, v1
  v_xor_b32 v2, 0x80, v1
  s_setprio 3
  s_mov_b32 s65, 0
  s_mov_b32 m0, 0
  s_sub_u32 s26, 0x80000, s3
  s_mov_b32 s27, 0x20000
  s_waitcnt lgkmcnt(0)
  s_add_u32 s24, s6, s22
  s_addc_u32 s25, s7, 0
  buffer_load_dwordx4 v1, s[24:27], s65 offen offset:0 nt lds
  s_addk_i32 m0, 0x300
  s_lshl_b32 s3, s60, 13
  buffer_load_dwordx4 v2, s[24:27], s65 offen offset:256 nt lds
  s_addk_i32 m0, 0x300
  s_add_u32 s32, s4, s3
  s_addc_u32 s33, s5, 0
  buffer_load_dwordx4 v1, s[24:27], s65 offen offset:512 nt lds
  s_addk_i32 m0, 0x300
  s_mov_b32 s34, 8192
  buffer_load_dwordx4 v2, s[24:27], s65 offen offset:768 nt lds
  s_addk_i32 m0, 0x300
  s_mov_b32 s35, 0x20000
  buffer_load_dwordx4 v1, s[24:27], s65 offen offset:1024 nt lds
  s_addk_i32 m0, 0x300
  v_lshlrev_b32 v3, 8, v9
  buffer_load_dwordx4 v2, s[24:27], s65 offen offset:1280 nt lds
  s_addk_i32 m0, 0x300
  v_lshl_add_u32 v3, v10, 4, v3
  buffer_load_dwordx4 v1, s[24:27], s65 offen offset:1536 nt lds
  s_addk_i32 m0, 0x300
  v_xor_b32 v4, 0x80, v3
  buffer_load_dwordx4 v2, s[24:27], s65 offen offset:1792 nt lds
  s_addk_i32 m0, 0x300
  s_movk_i32 s73, 0x1000
  buffer_load_dwordx4 v1, s[24:27], s65 offen offset:2048 nt lds
  s_addk_i32 m0, 0x300
  s_mov_b32 s66, 0
  buffer_load_dwordx4 v2, s[24:27], s65 offen offset:2304 nt lds
  s_addk_i32 m0, 0x300
  s_mov_b32 s64, 31
  buffer_load_dwordx4 v1, s[24:27], s65 offen offset:2560 nt lds
  s_addk_i32 m0, 0x300
  s_nop 0
  buffer_load_dwordx4 v2, s[24:27], s65 offen offset:2816 nt lds
  s_addk_i32 m0, 0x300
  s_nop 0
  buffer_load_dwordx4 v1, s[24:27], s65 offen offset:3072 nt lds
  s_addk_i32 m0, 0x300
  s_nop 0
  buffer_load_dwordx4 v2, s[24:27], s65 offen offset:3328 nt lds
  s_addk_i32 m0, 0x300
  s_nop 0
  buffer_load_dwordx4 v1, s[24:27], s65 offen offset:3584 nt lds
  s_addk_i32 m0, 0x300
  s_nop 0
  buffer_load_dwordx4 v2, s[24:27], s65 offen offset:3840 nt lds
  s_mov_b32 m0, 81920
  s_nop 0
  buffer_load_dwordx4 v3, s[32:35], 0 offen offset:0  lds
  buffer_load_dwordx4 v4, s[32:35], 0 offen offset:1024  lds
  buffer_load_dwordx4 v3, s[32:35], 0 offen offset:2048  lds
  buffer_load_dwordx4 v4, s[32:35], 0 offen offset:3072  lds
  s_mov_b32 m0, 86016
  s_nop 0
  buffer_load_dwordx4 v3, s[32:35], s73 offen offset:0  lds
  buffer_load_dwordx4 v4, s[32:35], s73 offen offset:1024  lds
  buffer_load_dwordx4 v3, s[32:35], s73 offen offset:2048  lds
  buffer_load_dwordx4 v4, s[32:35], s73 offen offset:3072  lds
  v_lshrrev_b32 v7, 3, v0
  v_and_b32 v8, 6, v7
  v_xor_b32 v8, v8, v0
  v_and_b32 v8, 7, v8
  v_lshlrev_b32 v8, 4, v8
  v_and_b32 v5, 3, v7
  v_lshl_add_u32 v5, v5, 12, v8
  v_lshrrev_b32 v7, 2, v7
  v_lshl_add_u32 v5, v7, 8, v5
  v_add_u32 v6, 32768, v5
  s_lshr_b32 s76, s2, 3
  s_and_b32 s3, s2, 7
  s_lshl_b32 s3, s3, 5
  s_add_u32 s56, s18, s3
  s_addc_u32 s57, s19, 0
  s_mov_b32 s58, 32
  s_mov_b32 s59, 0x20000
  v_mov_b32 v14, 0
  v_mov_b32 v15, 1
  v_lshlrev_b32 v16, 5, v0
  s_getreg_b32 s2, hwreg(HW_REG_XCC_ID)
  s_and_b32 s2, s2, 7
  s_mul_i32 s2, s2, 5
  s_mov_b32 s30, 0x6d3d5b36
  s_mov_b32 s31, 0x000000c5
  s_lshr_b64 s[30:31], s[30:31], s2
  s_and_b32 s78, s30, 31
L_lk:
  s_add_u32 s65, s65, 32768
  s_add_u32 s66, s66, 0x4000
  s_cmp_ge_u32 s66, 81920
  s_cselect_b32 s77, 81920, 0
  s_sub_u32 s66, s66, s77
  s_bitcmp1_b32 s64, 0
  s_cbranch_scc0 L_f1
  v_cmp_ge_u32 vcc, v14, v15
  v_add_u32 v15, 1, v15
  s_bcnt1_i32_b64 s2, vcc
  buffer_load_ubyte v14, v0, s[56:59], 0 offen nt
  buffer_store_byte v15, v16, s[56:59], s76 offen
L_d1:
  s_cmp_ge_u32 s2, s78
  s_cselect_b64 vcc, -1, 0
L_f1:
  s_mov_b32 m0, s66
  s_waitcnt vmcnt(24)
  s_cbranch_vccnz L_g2
  s_waitcnt vmcnt(20)
L_g2:
  buffer_load_dwordx4 v1, s[24:27], s65 offen offset:0 nt lds
  s_addk_i32 m0, 0x300
  s_waitcnt vmcnt(24)
  s_cbranch_vccnz L_g3
  s_waitcnt vmcnt(20)
L_g3:
  buffer_load_dwordx4 v2, s[24:27], s65 offen offset:256 nt lds
  s_addk_i32 m0, 0x300
  s_waitcnt vmcnt(24)
  s_cbranch_vccnz L_g4
  s_waitcnt vmcnt(20)
L_g4:
  buffer_load_dwordx4 v1, s[24:27], s65 offen offset:512 nt lds
  s_addk_i32 m0, 0x300
  s_waitcnt vmcnt(24)
  s_cbranch_vccnz L_g5
  s_waitcnt vmcnt(20)
L_g5:
  buffer_load_dwordx4 v2, s[24:27], s65 offen offset:768 nt lds
  s_addk_i32 m0, 0x300
  s_waitcnt vmcnt(24)
  s_cbranch_vccnz L_g6
  s_waitcnt vmcnt(20)
L_g6:
  buffer_load_dwordx4 v1, s[24:27], s65 offen offset:1024 nt lds
  s_addk_i32 m0, 0x300
  s_waitcnt vmcnt(24)
  s_cbranch_vccnz L_g7
  s_waitcnt vmcnt(20)
L_g7:
  buffer_load_dwordx4 v2, s[24:27], s65 offen offset:1280 nt lds
  s_addk_i32 m0, 0x300
  s_waitcnt vmcnt(24)
  s_cbranch_vccnz L_g8
  s_waitcnt vmcnt(20)
L_g8:
  buffer_load_dwordx4 v1, s[24:27], s65 offen offset:1536 nt lds
  s_addk_i32 m0, 0x300
  s_waitcnt vmcnt(24)
  s_cbranch_vccnz L_g9
  s_waitcnt vmcnt(20)
L_g9:
  buffer_load_dwordx4 v2, s[24:27], s65 offen offset:1792 nt lds
  s_addk_i32 m0, 0x300
  s_waitcnt vmcnt(24)
  s_cbranch_vccnz L_g10
  s_waitcnt vmcnt(20)
L_g10:
  buffer_load_dwordx4 v1, s[24:27], s65 offen offset:2048 nt lds
  s_cmp_eq_u32 s64, 31
  s_cbranch_scc1 L_lkb
  s_barrier
L_lkb:
  s_addk_i32 m0, 0x300
  s_waitcnt vmcnt(24)
  s_cbranch_vccnz L_g11
  s_waitcnt vmcnt(20)
L_g11:
  buffer_load_dwordx4 v2, s[24:27], s65 offen offset:2304 nt lds
  s_addk_i32 m0, 0x300
  s_waitcnt vmcnt(24)
  s_cbranch_vccnz L_g12
  s_waitcnt vmcnt(20)
L_g12:
  buffer_load_dwordx4 v1, s[24:27], s65 offen offset:2560 nt lds
  s_addk_i32 m0, 0x300
  s_waitcnt vmcnt(24)
  s_cbranch_vccnz L_g13
  s_waitcnt vmcnt(20)
L_g13:
  buffer_load_dwordx4 v2, s[24:27], s65 offen offset:2816 nt lds
  s_addk_i32 m0, 0x300
  s_waitcnt vmcnt(24)
  s_cbranch_vccnz L_g14
  s_waitcnt vmcnt(20)
L_g14:
  buffer_load_dwordx4 v1, s[24:27], s65 offen offset:3072 nt lds
  s_addk_i32 m0, 0x300
  s_waitcnt vmcnt(24)
  s_cbranch_vccnz L_g15
  s_waitcnt vmcnt(20)
L_g15:
  buffer_load_dwordx4 v2, s[24:27], s65 offen offset:3328 nt lds
  s_addk_i32 m0, 0x300
  s_waitcnt vmcnt(24)
  s_cbranch_vccnz L_g16
  s_waitcnt vmcnt(20)
L_g16:
  buffer_load_dwordx4 v1, s[24:27], s65 offen offset:3584 nt lds
  s_addk_i32 m0, 0x300
  s_waitcnt vmcnt(24)
  s_cbranch_vccnz L_g17
  s_waitcnt vmcnt(20)
L_g17:
  buffer_load_dwordx4 v2, s[24:27], s65 offen offset:3840 nt lds
  s_sub_u32 s64, s64, 1
  s_cmp_lg_u32 s64, 16
  s_cbranch_scc1 L_lk
  s_add_u32 s24, s8, s22
  s_addc_u32 s25, s9, 0
  s_lshl_b32 s71, s61, 7
  s_xor_b32 s65, s71, 0x80
L_lv:
  s_add_u32 s66, s66, 0x4000
L_h8:
  s_cbranch_execz L_hret
  s_cmp_ge_u32 s66, 81920
  s_cselect_b32 s77, 81920, 0
  s_sub_u32 s66, s66, s77
  s_bitcmp1_b32 s64, 0
  s_cbranch_scc0 L_f18
  v_cmp_ge_u32 vcc, v14, v15
  v_add_u32 v15, 1, v15
  s_bcnt1_i32_b64 s2, vcc
  s_cmp_eq_u32 s64, 1
  s_cbranch_scc1 L_d18
  buffer_load_ubyte v14, v0, s[56:59], 0 offen nt
  buffer_store_byte v15, v16, s[56:59], s76 offen
L_d18:
  s_cmp_ge_u32 s2, s78
  s_cselect_b64 vcc, -1, 0
L_f18:
  s_mov_b32 m0, s66
  s_waitcnt vmcnt(24)
  s_cbranch_vccnz L_g19
  s_waitcnt vmcnt(20)
L_g19:
  buffer_load_dwordx4 v5, s[24:27], s65 offen offset:0 nt lds
  s_addk_i32 m0, 0x200
  s_waitcnt vmcnt(24)
  s_cbranch_vccnz L_g20
  s_waitcnt vmcnt(20)
L_g20:
  buffer_load_dwordx4 v5, s[24:27], s65 offen offset:512 nt lds
L_h9:
  s_cbranch_execz L_hret
  s_addk_i32 m0, 0x200
  s_waitcnt vmcnt(24)
  s_cbranch_vccnz L_g21
  s_waitcnt vmcnt(20)
L_g21:
  buffer_load_dwordx4 v5, s[24:27], s65 offen offset:1024 nt lds
  s_addk_i32 m0, 0x200
  s_waitcnt vmcnt(24)
  s_cbranch_vccnz L_g22
  s_waitcnt vmcnt(20)
L_g22:
  buffer_load_dwordx4 v5, s[24:27], s65 offen offset:1536 nt lds
  s_addk_i32 m0, 0x200
  s_waitcnt vmcnt(24)
  s_cbranch_vccnz L_g23
  s_waitcnt vmcnt(20)
L_g23:
  buffer_load_dwordx4 v5, s[24:27], s65 offen offset:2048 nt lds
  s_addk_i32 m0, 0x200
  s_waitcnt vmcnt(24)
  s_cbranch_vccnz L_g24
  s_waitcnt vmcnt(20)
L_g24:
  buffer_load_dwordx4 v5, s[24:27], s65 offen offset:2560 nt lds
  s_addk_i32 m0, 0x200
  s_waitcnt vmcnt(24)
  s_cbranch_vccnz L_g25
  s_waitcnt vmcnt(20)
L_g25:
  buffer_load_dwordx4 v5, s[24:27], s65 offen offset:3072 nt lds
  s_addk_i32 m0, 0x200
L_h10:
  s_cbranch_execz L_hret
  s_waitcnt vmcnt(24)
  s_cbranch_vccnz L_g26
  s_waitcnt vmcnt(20)
L_g26:
  buffer_load_dwordx4 v5, s[24:27], s65 offen offset:3584 nt lds
  s_addk_i32 m0, 0x1200
  s_waitcnt vmcnt(24)
  s_cbranch_vccnz L_g27
  s_waitcnt vmcnt(20)
L_g27:
  buffer_load_dwordx4 v6, s[24:27], s65 offen offset:0 nt lds
  s_barrier
  s_addk_i32 m0, 0x200
  s_waitcnt vmcnt(24)
  s_cbranch_vccnz L_g28
  s_waitcnt vmcnt(20)
L_g28:
  buffer_load_dwordx4 v6, s[24:27], s65 offen offset:512 nt lds
  s_addk_i32 m0, 0x200
  s_waitcnt vmcnt(24)
  s_cbranch_vccnz L_g29
  s_waitcnt vmcnt(20)
L_g29:
  buffer_load_dwordx4 v6, s[24:27], s65 offen offset:1024 nt lds
  s_addk_i32 m0, 0x200
  s_waitcnt vmcnt(24)
  s_cbranch_vccnz L_g30
  s_waitcnt vmcnt(20)
L_g30:
  buffer_load_dwordx4 v6, s[24:27], s65 offen offset:1536 nt lds
  s_addk_i32 m0, 0x200
L_h11:
  s_cbranch_execz L_hret
  s_waitcnt vmcnt(24)
  s_cbranch_vccnz L_g31
  s_waitcnt vmcnt(20)
L_g31:
  buffer_load_dwordx4 v6, s[24:27], s65 offen offset:2048 nt lds
  s_addk_i32 m0, 0x200
  s_waitcnt vmcnt(24)
  s_cbranch_vccnz L_g32
  s_waitcnt vmcnt(20)
L_g32:
  buffer_load_dwordx4 v6, s[24:27], s65 offen offset:2560 nt lds
  s_addk_i32 m0, 0x200
  s_waitcnt vmcnt(24)
  s_cbranch_vccnz L_g33
  s_waitcnt vmcnt(20)
L_g33:
  buffer_load_dwordx4 v6, s[24:27], s65 offen offset:3072 nt lds
  s_addk_i32 m0, 0x200
  s_waitcnt vmcnt(24)
  s_cbranch_vccnz L_g34
  s_waitcnt vmcnt(20)
L_g34:
  buffer_load_dwordx4 v6, s[24:27], s65 offen offset:3584 nt lds
  s_add_u32 s65, s65, 65536
  s_sub_u32 s64, s64, 1
  s_cmp_eq_u32 s64, 8
  s_cselect_b32 s65, s71, s65
  s_cmp_lg_u32 s64, 0
  s_cbranch_scc1 L_lv
  s_waitcnt vmcnt(16)
L_h12:
  s_cbranch_execz L_hret
  s_barrier
  s_waitcnt vmcnt(0)
  s_barrier
  s_endpgm
L_comp:
  s_load_dwordx2 s[20:21], s[0:1], 64
  s_lshl_b32 s70, s62, 12
  s_and_b32 s23, s2, 7
  s_lshl_b32 s23, s23, 5
  s_lshr_b32 s58, s2, 3
  s_or_b32 s58, s58, s62
  s_cselect_b32 s58, 0, 1
  v_lshlrev_b32 v1, 8, v9
  v_lshl_add_u32 v1, v10, 4, v1
  s_and_b32 s2, s62, 1
  s_lshl_b32 s2, s2, 7
  v_xor_b32 v1, s2, v1
  v_and_b32 v2, 7, v0
  v_lshlrev_b32 v2, 4, v2
  v_lshl_add_u32 v2, v9, 3, v2
  v_lshrrev_b32 v11, 5, v0
  v_lshl_add_u32 v2, v11, 7, v2
  v_and_b32 v10, 15, v0
  v_and_b32 v11, 7, v0
  v_lshlrev_b32 v11, 1, v11
  v_xor_b32 v11, v11, v9
  v_lshlrev_b32 v3, 8, v10
  v_lshl_add_u32 v3, v11, 4, v3
  v_xor_b32 v4, 64, v3
  v_xor_b32 v5, 128, v3
  v_xor_b32 v6, 192, v3
  v_and_b32 v233, 31, v0
  v_lshlrev_b32 v233, 8, v233
  v_lshrrev_b32 v11, 5, v0
  v_lshl_add_u32 v233, v11, 4, v233
  s_lshl2_add_u32 s2, s61, s62
  s_lshl_b32 s3, s2, 5
  v_add_u32 v233, s3, v233
  v_lshrrev_b32 v10, 2, v0
  v_bfe_u32 v12, v0, 1, 1
  v_and_b32 v13, 1, v0
  v_lshlrev_b32 v13, 3, v13
  s_lshl_b32 s2, s2, 1
  v_add_u32 v14, s2, v12
  v_and_b32 v11, 7, v10
  v_lshlrev_b32 v11, 1, v11
  v_xor_b32 v11, v11, v14
  v_lshl_add_u32 v8, v10, 8, v13
  v_lshl_add_u32 v8, v11, 4, v8
  v_add_u32 v8, 151552, v8
  v_and_b32 v14, 7, v14
  v_and_b32 v11, 6, v10
  v_xor_b32 v11, v11, v14
  v_lshl_add_u32 v7, v10, 7, v13
  v_lshl_add_u32 v7, v11, 4, v7
  v_lshlrev_b32 v11, 3, v0
  v_add_u32 v9, 81920, v11
  s_lshr_b32 s2, s70, 2
  v_add_u32 v10, s2, v9
  v_add_u32 v232, 155648, v11
  s_waitcnt lgkmcnt(0)
  s_lshl_b32 s71, s60, 11
  s_add_u32 s36, s10, s71
  s_addc_u32 s37, s11, 0
  s_mov_b32 s38, 2048
  s_mov_b32 s39, 0x20000
  s_add_u32 s40, s12, s71
  s_addc_u32 s41, s13, 0
  s_mov_b32 s42, 2048
  s_mov_b32 s43, 0x20000
  s_lshr_b32 s71, s60, 3
  s_lshl_b32 s71, s71, 7
  s_add_u32 s44, s14, s71
  s_addc_u32 s45, s15, 0
  s_mov_b32 s46, 128
  s_mov_b32 s47, 0x20000
  s_lshl_b32 s3, s60, 13
  s_add_u32 s48, s16, s3
  s_addc_u32 s49, s17, 0
  s_mov_b32 s50, 8192
  s_mov_b32 s51, 0x20000
  s_add_u32 s56, s18, s23
  s_addc_u32 s57, s19, 0
  s_mov_b32 s59, 0x20000
  s_lshl_b32 s71, s60, 10
  s_add_u32 s52, s20, s71
  s_addc_u32 s53, s21, 0
  s_mov_b32 s54, 1024
  s_mov_b32 s55, 0x20000
  s_lshl_b32 s31, s62, 11
  s_lshl_b32 s2, s61, 7
  s_add_u32 s31, s31, s2
  s_xor_b32 s30, s31, 0x80
  v_lshrrev_b32 v11, 3, v0
  v_and_b32 v234, 7, v0
  v_lshlrev_b32 v234, 4, v234
  v_lshl_add_u32 v234, v11, 8, v234
  s_mul_i32 s28, s61, 384
  s_sub_u32 s29, 384, s28
  s_lshl2_add_u32 s73, s62, s29
  s_add_u32 s73, s73, 0x80
  v_lshlrev_b32 v228, 2, v0
  s_lshl2_add_u32 s2, s62, 0x80
  v_cmp_lt_u32 vcc, 32, v0
  v_mov_b32 v11, 0x10000
  v_writelane_b32 v228, s2, 32
  v_cndmask_b32 v228, v228, v11, vcc
  v_and_b32 v229, 31, v0
  v_lshlrev_b32 v229, 2, v229
  s_mov_b32 s72, 0x3e0293ee
  s_mov_b32 s64, 16
  s_mov_b32 s67, s70
  s_mov_b32 s68, 0
  s_mov_b32 s69, 0
  v_mov_b32 v12, 0xff61b1e6
  v_mov_b32 v16, 0
  v_mov_b32 v13, 0xff61b1e6
  v_mov_b32 v17, 0
  v_add_u32 v18, 81920, v3
  v_add_u32 v19, 81920, v4
  v_add_u32 v20, 81920, v5
  v_add_u32 v21, 81920, v6
  s_sub_u32 s78, s62, 12
  s_mov_b32 s76, 0x200000
  buffer_load_dword v11, off, s[52:55], 0 offset:768
  s_lshl_b32 s3, s62, 10
  s_add_u32 m0, s3, 147456
  s_nop 0
  buffer_load_dwordx4 v1, s[36:39], s3 offen  lds
  s_add_u32 m0, s3, 151552
  s_nop 0
  buffer_load_dwordx4 v1, s[40:43], s3 offen  lds
  buffer_load_dwordx2 v[230:231], v2, s[44:47], 0 offen
L_k:
  s_cmp_ge_u32 s78, 13
  s_cbranch_scc1 L_hskip
  s_mov_b64 exec, 0
  s_cmp_eq_u32 s78, 0
  s_cbranch_scc1 L_h0
  s_cmp_eq_u32 s78, 1
  s_cbranch_scc1 L_h1
  s_cmp_eq_u32 s78, 2
  s_cbranch_scc1 L_h2
  s_cmp_eq_u32 s78, 3
  s_cbranch_scc1 L_h3
  s_cmp_eq_u32 s78, 4
  s_cbranch_scc1 L_h4
  s_cmp_eq_u32 s78, 5
  s_cbranch_scc1 L_h5
  s_cmp_eq_u32 s78, 6
  s_cbranch_scc1 L_h6
  s_cmp_eq_u32 s78, 7
  s_cbranch_scc1 L_h7
  s_cmp_eq_u32 s78, 8
  s_cbranch_scc1 L_h8
  s_cmp_eq_u32 s78, 9
  s_cbranch_scc1 L_h9
  s_cmp_eq_u32 s78, 10
  s_cbranch_scc1 L_h10
  s_cmp_eq_u32 s78, 11
  s_cbranch_scc1 L_h11
  s_cmp_eq_u32 s78, 12
  s_cbranch_scc1 L_h12
L_hret:
  s_mov_b64 exec, -1
L_hskip:
  s_add_u32 s78, s78, 4
  s_barrier
  s_cmp_lg_u32 s68, 0
  s_cbranch_scc1 L_k1
  ds_read_b128 v[176:179], v18 offset:0
  ds_read_b128 v[180:183], v19 offset:0
  ds_read_b128 v[184:187], v20 offset:0
  ds_read_b128 v[188:191], v21 offset:0
  ds_read_b128 v[192:195], v18 offset:4096
  ds_read_b128 v[196:199], v19 offset:4096
  ds_read_b128 v[200:203], v20 offset:4096
  ds_read_b128 v[204:207], v21 offset:4096
L_k1:
  v_add_u32 v18, s67, v3
  ds_read_b128 v[160:163], v18
  v_add_u32 v19, s67, v4
  ds_read_b128 v[164:167], v19
  v_add_u32 v20, s67, v5
  ds_read_b128 v[168:171], v20
  v_add_u32 v21, s67, v6
  ds_read_b128 v[172:175], v21
  s_add_u32 s67, s67, 0x4000
  s_cmp_ge_u32 s67, 81920
  s_cselect_b32 s77, 81920, 0
  s_sub_u32 s67, s67, s77
  s_waitcnt lgkmcnt(3)
  v_mfma_f32_16x16x32_bf16 v[24:27], v[160:163], v[176:179], 0
  v_mfma_f32_16x16x32_bf16 v[28:31], v[160:163], v[192:195], 0
  s_waitcnt lgkmcnt(2)
  v_mfma_f32_16x16x32_bf16 v[24:27], v[164:167], v[180:183], v[24:27]
  v_mfma_f32_16x16x32_bf16 v[28:31], v[164:167], v[196:199], v[28:31]
  s_waitcnt lgkmcnt(1)
  v_mfma_f32_16x16x32_bf16 v[24:27], v[168:171], v[184:187], v[24:27]
  v_mfma_f32_16x16x32_bf16 v[28:31], v[168:171], v[200:203], v[28:31]
  s_waitcnt lgkmcnt(0)
  v_mfma_f32_16x16x32_bf16 v[24:27], v[172:175], v[188:191], v[24:27]
  v_mfma_f32_16x16x32_bf16 v[28:31], v[172:175], v[204:207], v[28:31]
  s_nop 7
  v_max3_f32 v12, v12, v24, v25
  v_max3_f32 v13, v13, v28, v29
  v_max3_f32 v12, v12, v26, v27
  v_max3_f32 v13, v13, v30, v31
  s_set_gpr_idx_on s68, gpr_idx(DST)
  v_mov_b32 v32, v24
  v_mov_b32 v33, v25
  v_mov_b32 v34, v26
  v_mov_b32 v35, v27
  v_mov_b32 v36, v28
  v_mov_b32 v37, v29
  v_mov_b32 v38, v30
  v_mov_b32 v39, v31
  s_set_gpr_idx_off
  s_add_u32 s68, s68, 8
  s_sub_u32 s64, s64, 1
  s_cmp_gt_u32 s64, 7
  s_cbranch_scc1 L_k
  s_cmp_eq_u32 s64, 7
  s_cbranch_scc1 L_e0
  s_cmp_eq_u32 s64, 5
  s_cbranch_scc1 L_e1
  s_cmp_eq_u32 s64, 4
  s_cbranch_scc1 L_e2
  s_cmp_eq_u32 s64, 3
  s_cbranch_scc1 L_e3
  s_cmp_eq_u32 s64, 2
  s_cbranch_scc1 L_e4
  s_cmp_lg_u32 s64, 0
  s_cbranch_scc1 L_k
  s_nop 1
  v_permlane32_swap_b32 v12, v13
  v_max_f32 v12, v12, v13
  v_mov_b32 v13, v12
  s_nop 1
  v_permlane16_swap_b32 v12, v13
  v_max_f32 v12, v12, v13
  v_mov_b32 v13, v12
  s_nop 1
  v_permlane32_swap_b32 v12, v13
  s_lshr_b32 s2, s70, 3
  v_add_u32 v18, s2, v232
  ds_write_b64 v18, v[12:13]
  v_mov_b32 v21, 147456
  v_mov_b32 v22, 0
  ds_write_b32 v21, v22
  s_sub_u32 s67, s67, s70
  s_mov_b32 s64, 16
  s_mov_b32 s68, 0
  s_mov_b32 s79, 2
  s_mov_b32 s74, 0
  v_mov_b64 v[208:209], 0
  v_mov_b64 v[210:211], 0
  v_mov_b64 v[212:213], 0
  v_mov_b64 v[214:215], 0
  s_waitcnt lgkmcnt(0)
  s_barrier
  ds_read2st64_b64 v[216:219], v232 offset0:0 offset1:1
  ds_read2st64_b64 v[220:223], v232 offset0:2 offset1:3
  s_waitcnt lgkmcnt(0)
  v_max3_f32 v12, v216, v218, v220
  v_max_f32 v12, v12, v222
  v_mul_f32 v14, s72, v12
  v_max3_f32 v13, v217, v219, v221
  v_max_f32 v13, v13, v223
  v_mul_f32 v15, s72, v13
L_pc:
  s_set_gpr_idx_on s68, gpr_idx(SRC0)
  v_fma_f32 v24, v32, s72, -v14
  v_fma_f32 v25, v33, s72, -v14
  v_fma_f32 v26, v34, s72, -v14
  v_fma_f32 v27, v35, s72, -v14
  v_fma_f32 v28, v36, s72, -v15
  v_fma_f32 v29, v37, s72, -v15
  v_fma_f32 v30, v38, s72, -v15
  v_fma_f32 v31, v39, s72, -v15
  s_set_gpr_idx_off
  v_exp_f32 v24, v24
  v_exp_f32 v28, v28
  v_exp_f32 v25, v25
  v_exp_f32 v29, v29
  v_exp_f32 v26, v26
  v_exp_f32 v30, v30
  v_exp_f32 v27, v27
  v_exp_f32 v31, v31
  s_add_u32 s68, s68, 8
  v_add_f32 v16, v16, v24
  v_add_f32 v17, v17, v28
  v_add_f32 v16, v16, v25
  v_add_f32 v17, v17, v29
  v_add_f32 v16, v16, v26
  v_add_f32 v17, v17, v30
  v_add_f32 v16, v16, v27
  v_add_f32 v17, v17, v31
  v_cvt_pk_bf16_f32 v224, v24, v25
  v_cvt_pk_bf16_f32 v225, v26, v27
  v_cvt_pk_bf16_f32 v226, v28, v29
  v_cvt_pk_bf16_f32 v227, v30, v31
  ds_write2st64_b64 v10, v[224:225], v[226:227] offset0:0 offset1:1
  v_add_u32 v10, 0x1000, v10
  s_sub_u32 s79, s79, 1
  s_cmp_lg_u32 s79, 0
  s_cbranch_scc1 L_pc
  s_mov_b32 s79, 2
  s_cmp_lg_u32 s68, 128
  s_cbranch_scc1 L_vb
  s_nop 1
  v_permlane32_swap_b32 v16, v17
  v_add_f32 v16, v16, v17
  v_mov_b32 v17, v16
  s_nop 1
  v_permlane16_swap_b32 v16, v17
  v_add_f32 v16, v16, v17
  v_mov_b32 v17, v16
  s_nop 1
  v_permlane32_swap_b32 v16, v17
  s_lshr_b32 s2, s70, 3
  v_add_u32 v18, s2, v232
  ds_write_b64 v18, v[16:17] offset:2048
L_vb:
  s_mov_b32 s63, 1
  s_waitcnt lgkmcnt(0)
  s_barrier
L_v:
  v_add_u32 v19, s69, v9
  v_add_u32 v18, s67, v7
  ds_read2st64_b64 v[176:179], v19 offset0:0 offset1:2
  ds_read2st64_b64 v[180:183], v19 offset0:1 offset1:3
  ds_read2st64_b64 v[184:187], v19 offset0:4 offset1:6
  ds_read2st64_b64 v[188:191], v19 offset0:5 offset1:7
  ds_read2st64_b64 v[192:195], v19 offset0:8 offset1:10
  ds_read2st64_b64 v[196:199], v19 offset0:9 offset1:11
  ds_read2st64_b64 v[200:203], v19 offset0:12 offset1:14
  ds_read2st64_b64 v[204:207], v19 offset0:13 offset1:15
  s_add_u32 s67, s67, 0x4000
  s_cmp_ge_u32 s67, 81920
  s_cselect_b32 s77, 81920, 0
  s_sub_u32 s67, s67, s77
  s_add_u32 s69, s69, 0x2000
  s_and_b32 s69, s69, 0xffff
  s_sub_u32 s64, s64, 1
  s_cmp_lg_u32 s63, 0
  s_mov_b32 s63, 0
  s_waitcnt lgkmcnt(6)
  s_cbranch_scc1 L_v1
  s_barrier
L_v1:
  ds_read_b32 v20, v21
  ds_read_b64_tr_b16 v[160:161], v18 offset:0
  ds_read_b64_tr_b16 v[162:163], v18 offset:2048
  ds_read_b64_tr_b16 v[164:165], v18 offset:4096
  ds_read_b64_tr_b16 v[166:167], v18 offset:6144
  ds_read_b64_tr_b16 v[168:169], v18 offset:8192
  ds_read_b64_tr_b16 v[170:171], v18 offset:10240
  ds_read_b64_tr_b16 v[172:173], v18 offset:12288
  ds_read_b64_tr_b16 v[174:175], v18 offset:14336
  s_cmp_eq_u32 s64, 0
  s_waitcnt lgkmcnt(6)
  v_mfma_f32_16x16x32_bf16 v[208:211], v[160:163], v[176:179], v[208:211]
  v_mfma_f32_16x16x32_bf16 v[212:215], v[160:163], v[180:183], v[212:215]
  s_waitcnt lgkmcnt(4)
  v_mfma_f32_16x16x32_bf16 v[208:211], v[164:167], v[184:187], v[208:211]
  v_mfma_f32_16x16x32_bf16 v[212:215], v[164:167], v[188:191], v[212:215]
  s_waitcnt lgkmcnt(2)
  v_mfma_f32_16x16x32_bf16 v[208:211], v[168:171], v[192:195], v[208:211]
  v_mfma_f32_16x16x32_bf16 v[212:215], v[168:171], v[196:199], v[212:215]
  s_waitcnt lgkmcnt(0)
  v_mfma_f32_16x16x32_bf16 v[208:211], v[172:175], v[200:203], v[208:211]
  v_mfma_f32_16x16x32_bf16 v[212:215], v[172:175], v[204:207], v[212:215]
  s_cbranch_scc1 L_done
  s_cmp_le_u32 s64, 2
  s_cbranch_scc1 L_sm
  s_cmp_ge_u32 s64, 9
  s_cbranch_scc1 L_pc
  s_cmp_eq_u32 s64, 8
  s_cbranch_scc1 L_sw
  s_cmp_eq_u32 s64, 7
  s_cbranch_scc1 L_sw2
  s_cmp_eq_u32 s64, 4
  s_cbranch_scc1 L_ask
  s_cmp_eq_u32 s64, 6
  s_cselect_b32 s63, 1, 0
  s_branch L_v
L_sw:
  ds_read2st64_b64 v[216:219], v232 offset0:4 offset1:5
  ds_read2st64_b64 v[220:223], v232 offset0:6 offset1:7
L_h0:
  s_cbranch_execz L_hret
  s_waitcnt lgkmcnt(0)
  v_pk_add_f32 v[216:217], v[216:217], v[218:219]
  v_pk_add_f32 v[220:221], v[220:221], v[222:223]
  v_pk_add_f32 v[16:17], v[216:217], v[220:221]
  v_rcp_f32 v244, v16
  v_rcp_f32 v246, v17
  v_log_f32 v216, v16
  v_log_f32 v217, v17
  v_pk_mul_f32 v[208:209], v[208:209], v[244:245] op_sel_hi:[1,0]
  v_pk_mul_f32 v[210:211], v[210:211], v[244:245] op_sel_hi:[1,0]
  v_pk_mul_f32 v[212:213], v[212:213], v[246:247] op_sel_hi:[1,0]
  v_pk_mul_f32 v[214:215], v[214:215], v[246:247] op_sel_hi:[1,0]
  v_cvt_pk_bf16_f32 v32, v208, v209
  v_cvt_pk_bf16_f32 v33, v210, v211
  v_cvt_pk_bf16_f32 v34, v212, v213
  v_cvt_pk_bf16_f32 v35, v214, v215
  v_mov_b64 v[208:209], 0
  v_mov_b64 v[210:211], 0
  v_mov_b64 v[212:213], 0
  v_mov_b64 v[214:215], 0
L_h1:
  s_cbranch_execz L_hret
  s_branch L_v
L_sw2:
  s_waitcnt vmcnt(0)
  v_cmp_eq_u64 vcc, v[248:249], v[250:251]
  v_pk_add_f32 v[216:217], v[216:217], v[14:15]
  s_mov_b32 s2, 0xffff0000
  s_mov_b32 s3, 0xffff0000
  s_cmp_eq_u64 vcc, -1
  s_cselect_b32 s75, 1, 0
  v_cndmask_b32 v36, v216, v217, s[2:3]
  v_xor_b32 v32, v32, v235
  v_xor_b32 v33, v33, v235
  v_xor_b32 v34, v34, v235
  v_xor_b32 v35, v35, v235
  v_add3_u32 v37, v32, v33, v34
  v_add3_u32 v37, v35, v36, v37
  s_nop 1
  v_add_u32_dpp v37, v37, v37 row_ror:8 row_mask:0xf bank_mask:0xf
  s_nop 1
  v_add_u32_dpp v37, v37, v37 row_ror:4 row_mask:0xf bank_mask:0xf
  s_nop 1
  v_add_u32_dpp v37, v37, v37 row_ror:2 row_mask:0xf bank_mask:0xf
  s_nop 1
L_h2:
  s_cbranch_execz L_hret
  v_add_u32_dpp v37, v37, v37 row_ror:1 row_mask:0xf bank_mask:0xf
  v_readfirstlane_b32 s2, v11
  v_readlane_b32 s3, v37, 0
  s_add_u32 s2, s2, s3
  v_readlane_b32 s3, v37, 16
  s_add_u32 s2, s2, s3
  v_readlane_b32 s3, v37, 32
  s_add_u32 s2, s2, s3
  v_readlane_b32 s3, v37, 48
  s_add_u32 s2, s2, s3
  v_writelane_b32 v36, s2, 32
  s_cmp_eq_u32 s75, 1
  s_cbranch_scc1 L_sw1
  buffer_store_dwordx4 v[32:35], v234, s[48:51], s30 offen sc1
  buffer_store_dword v36, v228, s[52:55], s28 offen sc1
  s_branch L_v
L_sw1:
  buffer_store_dwordx4 v[32:35], v234, s[48:51], s30 offen
  buffer_store_dword v36, v228, s[52:55], s28 offen
  s_branch L_v
L_sm:
  s_cmp_eq_u32 s74, 3
  s_cbranch_scc1 L_v
L_h3:
  s_cbranch_execz L_hret
  s_waitcnt vmcnt(0)
  v_add3_u32 v48, v60, v61, v62
  v_add3_u32 v48, v63, v64, v48
  s_nop 1
  v_add_u32_dpp v48, v48, v48 row_ror:8 row_mask:0xf bank_mask:0xf
  s_nop 1
  v_add_u32_dpp v48, v48, v48 row_ror:4 row_mask:0xf bank_mask:0xf
  s_nop 1
  v_add_u32_dpp v48, v48, v48 row_ror:2 row_mask:0xf bank_mask:0xf
  s_nop 1
  v_add_u32_dpp v48, v48, v48 row_ror:1 row_mask:0xf bank_mask:0xf
  v_readfirstlane_b32 s2, v11
  v_readlane_b32 s3, v48, 0
  s_add_u32 s2, s2, s3
  v_readlane_b32 s3, v48, 16
  s_add_u32 s2, s2, s3
  v_readlane_b32 s3, v48, 32
  s_add_u32 s2, s2, s3
  v_readlane_b32 s3, v48, 48
  s_add_u32 s2, s2, s3
  v_readfirstlane_b32 s3, v65
L_h4:
  s_cbranch_execz L_hret
  s_cmp_eq_u32 s2, s3
  s_cbranch_scc1 L_hdr
  s_sub_u32 s76, s76, 1
  s_cbranch_scc1 L_hdr
L_ask:
  buffer_load_dwordx4 v[60:63], v234, s[48:51], s31 offen sc1
  buffer_load_dword v64, v229, s[52:55], s29 offen sc1
  buffer_load_dword v65, off, s[52:55], s73 sc1
  s_branch L_smx
L_hdr:
  buffer_store_byte v0, v234, s[56:59], 0 offen sc1
  v_mov_b32 v65, v64
  v_xor_b32 v60, v60, v235
  v_xor_b32 v61, v61, v235
  v_xor_b32 v62, v62, v235
  v_xor_b32 v63, v63, v235
  v_permlane16_swap_b32 v64, v65
  v_max3_f32 v48, v14, v64, v252
  v_max3_f32 v49, v15, v65, v253
  v_sub_f32 v244, v14, v48
  v_sub_f32 v52, v64, v48
  v_sub_f32 v56, v252, v48
  v_sub_f32 v246, v15, v49
  v_sub_f32 v54, v65, v49
  v_sub_f32 v58, v253, v49
  v_exp_f32 v244, v244
  v_exp_f32 v52, v52
L_h5:
  s_cbranch_execz L_hret
  v_exp_f32 v56, v56
  v_exp_f32 v246, v246
  v_exp_f32 v54, v54
  v_exp_f32 v58, v58
  s_mov_b32 s74, 3
  v_fma_f32 v48, v16, v244, v52
  v_fma_f32 v49, v17, v246, v54
  v_fmac_f32 v48, v254, v56
  v_fmac_f32 v49, v255, v58
  v_rcp_f32 v48, v48
  v_rcp_f32 v49, v49
  v_lshlrev_b32 v40, 16, v60
  v_and_b32 v41, 0xffff0000, v60
  v_lshlrev_b32 v42, 16, v61
  v_and_b32 v43, 0xffff0000, v61
  v_lshlrev_b32 v44, 16, v62
  v_and_b32 v45, 0xffff0000, v62
  v_lshlrev_b32 v46, 16, v63
  v_and_b32 v47, 0xffff0000, v63
  v_mul_f32 v244, v244, v48
  v_mul_f32 v52, v52, v48
  v_mul_f32 v56, v56, v48
  v_mul_f32 v246, v246, v49
  v_mul_f32 v54, v54, v49
  v_mul_f32 v58, v58, v49
L_h6:
  s_cbranch_execz L_hret
  v_pk_mul_f32 v[236:237], v[236:237], v[56:57] op_sel_hi:[1,0]
  v_pk_mul_f32 v[238:239], v[238:239], v[56:57] op_sel_hi:[1,0]
  v_pk_mul_f32 v[240:241], v[240:241], v[58:59] op_sel_hi:[1,0]
  v_pk_mul_f32 v[242:243], v[242:243], v[58:59] op_sel_hi:[1,0]
  v_pk_fma_f32 v[40:41], v[40:41], v[52:53], v[236:237] op_sel_hi:[1,0,1]
  v_pk_fma_f32 v[42:43], v[42:43], v[52:53], v[238:239] op_sel_hi:[1,0,1]
  v_pk_fma_f32 v[44:45], v[44:45], v[54:55], v[240:241] op_sel_hi:[1,0,1]
  v_pk_fma_f32 v[46:47], v[46:47], v[54:55], v[242:243] op_sel_hi:[1,0,1]
  s_cmp_eq_u32 s64, 0
  s_cbranch_scc1 L_smx
  s_mov_b64 exec, 1
  v_mov_b32 v22, 1
  ds_add_u32 v21, v22
  s_mov_b64 exec, -1
L_smx:
  s_cmp_lg_u32 s64, 0
  s_cbranch_scc1 L_v
L_done:
  s_cmp_lg_u32 s74, 3
  s_cbranch_scc1 L_sm
  v_readfirstlane_b32 s2, v20
  s_cmp_eq_u32 s2, 4
  s_cbranch_scc1 L_go
  s_barrier
L_go:
L_h7:
  s_cbranch_execz L_hret
  s_nop 1
  v_pk_fma_f32 v[208:209], v[208:209], v[244:245], v[40:41] op_sel_hi:[1,0,1]
  v_pk_fma_f32 v[210:211], v[210:211], v[244:245], v[42:43] op_sel_hi:[1,0,1]
  v_pk_fma_f32 v[212:213], v[212:213], v[246:247], v[44:45] op_sel_hi:[1,0,1]
  v_pk_fma_f32 v[214:215], v[214:215], v[246:247], v[46:47] op_sel_hi:[1,0,1]
  v_cvt_pk_bf16_f32 v160, v208, v209
  v_cvt_pk_bf16_f32 v161, v210, v211
  v_cvt_pk_bf16_f32 v162, v212, v213
  v_cvt_pk_bf16_f32 v163, v214, v215
  s_or_b32 s2, s61, s62
  s_cmp_eq_u32 s2, 0
  v_permlane16_swap_b32 v160, v162
  v_permlane16_swap_b32 v161, v163
  buffer_store_dwordx4 v[160:163], v233, s[48:51], 0 offen
  s_cbranch_scc0 L_fin
  s_mov_b64 exec, 1
  buffer_store_dword v11, off, s[52:55], 0 offset:768
  s_mov_b64 exec, -1
L_fin:
L_end:
  s_endpgm
L_e0:
  s_waitcnt vmcnt(0)
  v_add_u32 v11, 1, v11
  v_lshl_add_u32 v235, v0, 7, v11
  s_mov_b32 s2, 0x9e3779b1
  v_mul_lo_u32 v235, v235, s2
  s_getreg_b32 s75, hwreg(HW_REG_XCC_ID)
  v_mov_b32 v248, s75
  v_mov_b32 v249, v11
  s_cmp_lg_u32 s62, 0
  s_cbranch_scc1 L_k
  s_mov_b64 exec, 1
  buffer_store_dwordx2 v[248:249], off, s[52:55], s28 offset:256
  s_mov_b64 exec, -1
  s_branch L_k
L_e1:
  v_add_u32 v18, 147456, v3
  ds_read_b128 v[160:163], v18
  v_add_u32 v19, 147456, v4
  ds_read_b128 v[164:167], v19
  v_add_u32 v20, 147456, v5
  ds_read_b128 v[168:171], v20
  v_add_u32 v21, 147456, v6
  ds_read_b128 v[172:175], v21
  s_waitcnt lgkmcnt(3)
  v_mfma_f32_16x16x32_bf16 v[236:239], v[160:163], v[176:179], 0
  v_mfma_f32_16x16x32_bf16 v[240:243], v[160:163], v[192:195], 0
  s_waitcnt lgkmcnt(2)
  v_mfma_f32_16x16x32_bf16 v[236:239], v[164:167], v[180:183], v[236:239]
  v_mfma_f32_16x16x32_bf16 v[240:243], v[164:167], v[196:199], v[240:243]
  s_waitcnt lgkmcnt(1)
  v_mfma_f32_16x16x32_bf16 v[236:239], v[168:171], v[184:187], v[236:239]
  v_mfma_f32_16x16x32_bf16 v[240:243], v[168:171], v[200:203], v[240:243]
  s_waitcnt lgkmcnt(0)
  v_mfma_f32_16x16x32_bf16 v[236:239], v[172:175], v[188:191], v[236:239]
  v_mfma_f32_16x16x32_bf16 v[240:243], v[172:175], v[204:207], v[240:243]
  s_branch L_k
L_e2:
  v_lshlrev_b32 v216, 16, v230
  v_and_b32 v217, 0xffff0000, v230
  v_lshlrev_b32 v218, 16, v231
  v_and_b32 v219, 0xffff0000, v231
  v_sub_f32 v216, 1.0, v216
  v_sub_f32 v217, 1.0, v217
  v_sub_f32 v218, 1.0, v218
  v_sub_f32 v219, 1.0, v219
  v_mul_f32 v216, 0xd028965f, v216
  v_mul_f32 v217, 0xd028965f, v217
  v_mul_f32 v218, 0xd028965f, v218
  v_mul_f32 v219, 0xd028965f, v219
  v_add_f32 v236, v236, v216
  v_add_f32 v237, v237, v217
  v_add_f32 v238, v238, v218
  v_add_f32 v239, v239, v219
  v_max3_f32 v252, v236, v237, v238
  v_max_f32 v252, v252, v239
  v_add_f32 v240, v240, v216
  v_add_f32 v241, v241, v217
  v_add_f32 v242, v242, v218
  v_add_f32 v243, v243, v219
  v_max3_f32 v253, v240, v241, v242
  v_max_f32 v253, v253, v243
  s_nop 1
  v_permlane32_swap_b32 v252, v253
  v_max_f32 v252, v252, v253
  v_mov_b32 v253, v252
  s_nop 1
  v_permlane16_swap_b32 v252, v253
  v_max_f32 v252, v252, v253
  v_mov_b32 v253, v252
  s_nop 1
  v_permlane32_swap_b32 v252, v253
  s_branch L_k
L_e3:
  v_mul_f32 v252, s72, v252
  v_mul_f32 v253, s72, v253
  v_fma_f32 v236, v236, s72, -v252
  v_fma_f32 v237, v237, s72, -v252
  v_fma_f32 v238, v238, s72, -v252
  v_fma_f32 v239, v239, s72, -v252
  v_fma_f32 v240, v240, s72, -v253
  v_fma_f32 v241, v241, s72, -v253
  v_fma_f32 v242, v242, s72, -v253
  v_fma_f32 v243, v243, s72, -v253
  v_exp_f32 v236, v236
  v_exp_f32 v240, v240
  v_exp_f32 v237, v237
  v_exp_f32 v241, v241
  v_exp_f32 v238, v238
  v_exp_f32 v242, v242
  v_exp_f32 v239, v239
  v_exp_f32 v243, v243
  s_nop 0
  v_add_f32 v254, v236, v237
  v_add_f32 v18, v238, v239
  v_add_f32 v255, v240, v241
  v_add_f32 v19, v242, v243
  v_pk_add_f32 v[254:255], v[254:255], v[18:19]
  v_cvt_pk_bf16_f32 v218, v236, v237
  v_cvt_pk_bf16_f32 v219, v238, v239
  v_cvt_pk_bf16_f32 v220, v240, v241
  v_cvt_pk_bf16_f32 v221, v242, v243
  s_branch L_k
L_e4:
  buffer_load_dwordx2 v[250:251], off, s[52:55], s29 offset:256 sc1
  ds_read_b64_tr_b16 v[216:217], v8
  s_nop 1
  v_permlane32_swap_b32 v254, v255
  v_add_f32 v254, v254, v255
  v_mov_b32 v255, v254
  s_nop 1
  v_permlane16_swap_b32 v254, v255
  v_add_f32 v254, v254, v255
  v_mov_b32 v255, v254
  s_nop 1
  v_permlane32_swap_b32 v254, v255
  s_waitcnt lgkmcnt(0)
  v_mfma_f32_16x16x16_bf16 v[236:239], v[216:217], v[218:219], 0
  v_mfma_f32_16x16x16_bf16 v[240:243], v[216:217], v[220:221], 0
  s_branch L_k
.section .rodata,"a"
.p2align 6
.amdhsa_kernel standalone__tree_speculative_verify_tree_attention_over_candidate_token_tree__sampling_kernel
  .amdhsa_next_free_vgpr 256
  .amdhsa_next_free_sgpr 102
  .amdhsa_accum_offset 256
  .amdhsa_group_segment_fixed_size 0
  .amdhsa_kernarg_size 72
  .amdhsa_user_sgpr_count 2
  .amdhsa_user_sgpr_kernarg_segment_ptr 1
  .amdhsa_system_sgpr_workgroup_id_x 1
.end_amdhsa_kernel
```
